```python
import torch

def _softmax(x, axis=-1):
    return torch.softmax(x, dim=axis)
def _gelu(x):
    return torch.nn.functional.gelu(x, approximate="tanh")
def _silu(x):
    return torch.nn.functional.silu(x)
def _sigmoid(x):
    return torch.sigmoid(x)
def _layernorm(x, axis=-1, eps=1e-5):
    m = x.mean(dim=axis, keepdim=True)
    v = x.var(dim=axis, keepdim=True, unbiased=False)
    return (x - m) / torch.sqrt(v + eps)
def _scatter_add(tgt, idx, src, axis=0):
    return tgt.clone().index_add_(axis, idx, src)
def _segment_sum(src, seg, n):
    out = torch.zeros((n,) + src.shape[1:], dtype=src.dtype)
    return out.index_add_(0, seg, src)
def _pad(x, pw):
    flat = tuple(v for pair in reversed(pw) for v in pair)
    return torch.nn.functional.pad(x, flat)

kernel_name = 'standalone__kernel_systems_refs_featgraph__graph'

def setup_inputs():

    _w = (lambda a: (lambda t: t.to(torch.bfloat16) if t.is_floating_point() else t)(torch.as_tensor(a)))
    N, deg, D = 50000, 16, 64
    E = N * deg
    scale = D ** -0.5
    src = (lambda lo, hi, *s: torch.randint(lo, hi, s))(0, N, E).to(torch.int64)
    dst = (lambda lo, hi, *s: torch.randint(lo, hi, s))(0, N, E).to(torch.int64)
    return {
        "x": _w((lambda *s: torch.randn(*s, dtype=torch.bfloat16) * 0.8)(N, D)),
        "src": _w(src),
        "dst": _w(dst),
        "w_q": _w((lambda *s: torch.randn(*s, dtype=torch.bfloat16) * 0.8)(D, D) * scale),
        "w_v": _w((lambda *s: torch.randn(*s, dtype=torch.bfloat16) * 0.05)(D, D) * scale),
    }

def reference(x, src, dst, w_q, w_v):
    N, D = x.shape
    xs = x[src]
    xd = x[dst]
    q = xd @ w_q
    logits = torch.einsum('ed,ed->e', xs, q) * (float(D) ** -0.5)
    alpha = _sigmoid(logits)
    msg = alpha[:, None] * (xs @ w_v)
    return _segment_sum(msg, dst, N)
```

```asm
; @launch kernel=sort_kernel grid=(256,1,1) block=(256,1,1) lds=16384
; @launch kernel=standalone__kernel_systems_refs_featgraph__graph_kernel grid=(256,1,1) block=(1024,1,1) lds=129024
.amdgcn_target "amdgcn-amd-amdhsa--gfx950"
.text
.globl sort_kernel
.p2align 8
.type sort_kernel,@function
sort_kernel:
s_cmp_ge_u32 s2, 256
s_cbranch_scc1 L1end
s_load_dwordx4 s[4:7], s[0:1], 8
s_load_dwordx2 s[8:9], s[0:1], 56
s_waitcnt lgkmcnt(0)
s_mov_b32 s12, s4
s_mov_b32 s13, s5
s_mov_b32 s14, 3200000
s_mov_b32 s15, 0x20000
s_mov_b32 s16, s6
s_mov_b32 s17, s7
s_mov_b32 s18, 3200000
s_mov_b32 s19, 0x20000
s_mov_b32 s20, s8
s_mov_b32 s21, s9
s_mov_b32 s22, 4456448
s_mov_b32 s23, 0x20000
s_mov_b32 s40, 0
s_mov_b32 s41, 1024
s_mov_b32 s42, 2048
s_mov_b32 s43, 3072
s_mov_b32 s44, 4096
s_mov_b32 s45, 5120
s_mov_b32 s46, 6144
s_mov_b32 s47, 7168
s_mov_b32 s48, 8192
s_mov_b32 s49, 9216
s_mov_b32 s50, 10240
s_mov_b32 s51, 11264
s_mov_b32 s52, 12288
s_mul_i32 s24, s2, 12500
s_mov_b32 s25, 21913099
s_mov_b32 s26, 196
v_lshlrev_b32 v1, 2, v0
v_mov_b32 v2, 0
ds_write_b32 v1, v2
v_add_u32 v3, s24, v1
buffer_load_dword v10, v3, s[12:15], s40 offen
buffer_load_dword v30, v3, s[16:19], s40 offen
buffer_load_dword v11, v3, s[12:15], s41 offen
buffer_load_dword v31, v3, s[16:19], s41 offen
buffer_load_dword v12, v3, s[12:15], s42 offen
buffer_load_dword v32, v3, s[16:19], s42 offen
buffer_load_dword v13, v3, s[12:15], s43 offen
buffer_load_dword v33, v3, s[16:19], s43 offen
buffer_load_dword v14, v3, s[12:15], s44 offen
buffer_load_dword v34, v3, s[16:19], s44 offen
buffer_load_dword v15, v3, s[12:15], s45 offen
buffer_load_dword v35, v3, s[16:19], s45 offen
buffer_load_dword v16, v3, s[12:15], s46 offen
buffer_load_dword v36, v3, s[16:19], s46 offen
buffer_load_dword v17, v3, s[12:15], s47 offen
buffer_load_dword v37, v3, s[16:19], s47 offen
buffer_load_dword v18, v3, s[12:15], s48 offen
buffer_load_dword v38, v3, s[16:19], s48 offen
buffer_load_dword v19, v3, s[12:15], s49 offen
buffer_load_dword v39, v3, s[16:19], s49 offen
buffer_load_dword v20, v3, s[12:15], s50 offen
buffer_load_dword v40, v3, s[16:19], s50 offen
buffer_load_dword v21, v3, s[12:15], s51 offen
buffer_load_dword v41, v3, s[16:19], s51 offen
v_cmp_gt_u32 vcc, 53, v0
s_and_saveexec_b64 s[28:29], vcc
buffer_load_dword v22, v3, s[12:15], s52 offen
buffer_load_dword v42, v3, s[16:19], s52 offen
s_mov_b64 exec, s[28:29]
s_waitcnt vmcnt(0) lgkmcnt(0)
s_barrier
v_mov_b32 v2, 1
v_mul_hi_u32 v50, v30, s25
v_mul_lo_u32 v4, v50, s26
v_sub_u32 v4, v30, v4
v_lshl_or_b32 v10, v4, 16, v10
v_lshlrev_b32 v50, 2, v50
ds_add_rtn_u32 v30, v50, v2
v_mul_hi_u32 v51, v31, s25
v_mul_lo_u32 v4, v51, s26
v_sub_u32 v4, v31, v4
v_lshl_or_b32 v11, v4, 16, v11
v_lshlrev_b32 v51, 2, v51
ds_add_rtn_u32 v31, v51, v2
v_mul_hi_u32 v52, v32, s25
v_mul_lo_u32 v4, v52, s26
v_sub_u32 v4, v32, v4
v_lshl_or_b32 v12, v4, 16, v12
v_lshlrev_b32 v52, 2, v52
ds_add_rtn_u32 v32, v52, v2
v_mul_hi_u32 v53, v33, s25
v_mul_lo_u32 v4, v53, s26
v_sub_u32 v4, v33, v4
v_lshl_or_b32 v13, v4, 16, v13
v_lshlrev_b32 v53, 2, v53
ds_add_rtn_u32 v33, v53, v2
v_mul_hi_u32 v54, v34, s25
v_mul_lo_u32 v4, v54, s26
v_sub_u32 v4, v34, v4
v_lshl_or_b32 v14, v4, 16, v14
v_lshlrev_b32 v54, 2, v54
ds_add_rtn_u32 v34, v54, v2
v_mul_hi_u32 v55, v35, s25
v_mul_lo_u32 v4, v55, s26
v_sub_u32 v4, v35, v4
v_lshl_or_b32 v15, v4, 16, v15
v_lshlrev_b32 v55, 2, v55
ds_add_rtn_u32 v35, v55, v2
v_mul_hi_u32 v56, v36, s25
v_mul_lo_u32 v4, v56, s26
v_sub_u32 v4, v36, v4
v_lshl_or_b32 v16, v4, 16, v16
v_lshlrev_b32 v56, 2, v56
ds_add_rtn_u32 v36, v56, v2
v_mul_hi_u32 v57, v37, s25
v_mul_lo_u32 v4, v57, s26
v_sub_u32 v4, v37, v4
v_lshl_or_b32 v17, v4, 16, v17
v_lshlrev_b32 v57, 2, v57
ds_add_rtn_u32 v37, v57, v2
v_mul_hi_u32 v58, v38, s25
v_mul_lo_u32 v4, v58, s26
v_sub_u32 v4, v38, v4
v_lshl_or_b32 v18, v4, 16, v18
v_lshlrev_b32 v58, 2, v58
ds_add_rtn_u32 v38, v58, v2
v_mul_hi_u32 v59, v39, s25
v_mul_lo_u32 v4, v59, s26
v_sub_u32 v4, v39, v4
v_lshl_or_b32 v19, v4, 16, v19
v_lshlrev_b32 v59, 2, v59
ds_add_rtn_u32 v39, v59, v2
v_mul_hi_u32 v60, v40, s25
v_mul_lo_u32 v4, v60, s26
v_sub_u32 v4, v40, v4
v_lshl_or_b32 v20, v4, 16, v20
v_lshlrev_b32 v60, 2, v60
ds_add_rtn_u32 v40, v60, v2
v_mul_hi_u32 v61, v41, s25
v_mul_lo_u32 v4, v61, s26
v_sub_u32 v4, v41, v4
v_lshl_or_b32 v21, v4, 16, v21
v_lshlrev_b32 v61, 2, v61
ds_add_rtn_u32 v41, v61, v2
s_mov_b64 exec, vcc
v_mul_hi_u32 v62, v42, s25
v_mul_lo_u32 v4, v62, s26
v_sub_u32 v4, v42, v4
v_lshl_or_b32 v22, v4, 16, v22
v_lshlrev_b32 v62, 2, v62
ds_add_rtn_u32 v42, v62, v2
s_mov_b64 exec, s[28:29]
s_waitcnt lgkmcnt(0)
s_barrier
ds_read_b32 v5, v1
s_waitcnt lgkmcnt(0)
v_mov_b32 v6, v5
s_barrier
ds_write_b32 v1, v6
s_waitcnt lgkmcnt(0)
s_barrier
v_subrev_u32 v7, 4, v1
v_max_i32 v7, 0, v7
ds_read_b32 v7, v7
v_cmp_le_u32 vcc, 1, v0
s_waitcnt lgkmcnt(0)
v_cndmask_b32 v7, 0, v7, vcc
v_add_u32 v6, v6, v7
s_barrier
ds_write_b32 v1, v6
s_waitcnt lgkmcnt(0)
s_barrier
v_subrev_u32 v7, 8, v1
v_max_i32 v7, 0, v7
ds_read_b32 v7, v7
v_cmp_le_u32 vcc, 2, v0
s_waitcnt lgkmcnt(0)
v_cndmask_b32 v7, 0, v7, vcc
v_add_u32 v6, v6, v7
s_barrier
ds_write_b32 v1, v6
s_waitcnt lgkmcnt(0)
s_barrier
v_subrev_u32 v7, 16, v1
v_max_i32 v7, 0, v7
ds_read_b32 v7, v7
v_cmp_le_u32 vcc, 4, v0
s_waitcnt lgkmcnt(0)
v_cndmask_b32 v7, 0, v7, vcc
v_add_u32 v6, v6, v7
s_barrier
ds_write_b32 v1, v6
s_waitcnt lgkmcnt(0)
s_barrier
v_subrev_u32 v7, 32, v1
v_max_i32 v7, 0, v7
ds_read_b32 v7, v7
v_cmp_le_u32 vcc, 8, v0
s_waitcnt lgkmcnt(0)
v_cndmask_b32 v7, 0, v7, vcc
v_add_u32 v6, v6, v7
s_barrier
ds_write_b32 v1, v6
s_waitcnt lgkmcnt(0)
s_barrier
v_subrev_u32 v7, 64, v1
v_max_i32 v7, 0, v7
ds_read_b32 v7, v7
v_cmp_le_u32 vcc, 16, v0
s_waitcnt lgkmcnt(0)
v_cndmask_b32 v7, 0, v7, vcc
v_add_u32 v6, v6, v7
s_barrier
ds_write_b32 v1, v6
s_waitcnt lgkmcnt(0)
s_barrier
v_subrev_u32 v7, 128, v1
v_max_i32 v7, 0, v7
ds_read_b32 v7, v7
v_cmp_le_u32 vcc, 32, v0
s_waitcnt lgkmcnt(0)
v_cndmask_b32 v7, 0, v7, vcc
v_add_u32 v6, v6, v7
s_barrier
ds_write_b32 v1, v6
s_waitcnt lgkmcnt(0)
s_barrier
v_subrev_u32 v7, 256, v1
v_max_i32 v7, 0, v7
ds_read_b32 v7, v7
v_cmp_le_u32 vcc, 64, v0
s_waitcnt lgkmcnt(0)
v_cndmask_b32 v7, 0, v7, vcc
v_add_u32 v6, v6, v7
s_barrier
ds_write_b32 v1, v6
s_waitcnt lgkmcnt(0)
s_barrier
v_subrev_u32 v7, 512, v1
v_max_i32 v7, 0, v7
ds_read_b32 v7, v7
v_cmp_le_u32 vcc, 128, v0
s_waitcnt lgkmcnt(0)
v_cndmask_b32 v7, 0, v7, vcc
v_add_u32 v6, v6, v7
v_sub_u32 v6, v6, v5
s_barrier
ds_write_b32 v1, v6
v_lshl_or_b32 v7, v5, 16, v6
s_lshl_b32 s27, s2, 2
s_add_u32 s27, s27, 4194304
v_lshlrev_b32 v8, 10, v0
buffer_store_dword v7, v8, s[20:23], s27 offen
s_waitcnt lgkmcnt(0)
s_barrier
v_cmp_gt_u32 vcc, 53, v0
ds_read_b32 v50, v50
ds_read_b32 v51, v51
ds_read_b32 v52, v52
ds_read_b32 v53, v53
ds_read_b32 v54, v54
ds_read_b32 v55, v55
ds_read_b32 v56, v56
ds_read_b32 v57, v57
ds_read_b32 v58, v58
ds_read_b32 v59, v59
ds_read_b32 v60, v60
ds_read_b32 v61, v61
s_mov_b64 exec, vcc
ds_read_b32 v62, v62
s_waitcnt lgkmcnt(0)
s_mov_b64 exec, s[28:29]
v_add_u32 v4, v50, v30
v_lshlrev_b32 v4, 2, v4
ds_write_b32 v4, v10 offset:1024
s_mov_b64 exec, s[28:29]
v_add_u32 v4, v51, v31
v_lshlrev_b32 v4, 2, v4
ds_write_b32 v4, v11 offset:1024
s_mov_b64 exec, s[28:29]
v_add_u32 v4, v52, v32
v_lshlrev_b32 v4, 2, v4
ds_write_b32 v4, v12 offset:1024
s_mov_b64 exec, s[28:29]
v_add_u32 v4, v53, v33
v_lshlrev_b32 v4, 2, v4
ds_write_b32 v4, v13 offset:1024
s_mov_b64 exec, s[28:29]
v_add_u32 v4, v54, v34
v_lshlrev_b32 v4, 2, v4
ds_write_b32 v4, v14 offset:1024
s_mov_b64 exec, s[28:29]
v_add_u32 v4, v55, v35
v_lshlrev_b32 v4, 2, v4
ds_write_b32 v4, v15 offset:1024
s_mov_b64 exec, s[28:29]
v_add_u32 v4, v56, v36
v_lshlrev_b32 v4, 2, v4
ds_write_b32 v4, v16 offset:1024
s_mov_b64 exec, s[28:29]
v_add_u32 v4, v57, v37
v_lshlrev_b32 v4, 2, v4
ds_write_b32 v4, v17 offset:1024
s_mov_b64 exec, s[28:29]
v_add_u32 v4, v58, v38
v_lshlrev_b32 v4, 2, v4
ds_write_b32 v4, v18 offset:1024
s_mov_b64 exec, s[28:29]
v_add_u32 v4, v59, v39
v_lshlrev_b32 v4, 2, v4
ds_write_b32 v4, v19 offset:1024
s_mov_b64 exec, s[28:29]
v_add_u32 v4, v60, v40
v_lshlrev_b32 v4, 2, v4
ds_write_b32 v4, v20 offset:1024
s_mov_b64 exec, s[28:29]
v_add_u32 v4, v61, v41
v_lshlrev_b32 v4, 2, v4
ds_write_b32 v4, v21 offset:1024
s_mov_b64 exec, vcc
v_add_u32 v4, v62, v42
v_lshlrev_b32 v4, 2, v4
ds_write_b32 v4, v22 offset:1024
s_mov_b64 exec, s[28:29]
s_waitcnt lgkmcnt(0)
s_barrier
ds_read_b32 v10, v1 offset:1024
ds_read_b32 v11, v1 offset:2048
ds_read_b32 v12, v1 offset:3072
ds_read_b32 v13, v1 offset:4096
ds_read_b32 v14, v1 offset:5120
ds_read_b32 v15, v1 offset:6144
ds_read_b32 v16, v1 offset:7168
ds_read_b32 v17, v1 offset:8192
ds_read_b32 v18, v1 offset:9216
ds_read_b32 v19, v1 offset:10240
ds_read_b32 v20, v1 offset:11264
ds_read_b32 v21, v1 offset:12288
s_mov_b64 exec, vcc
ds_read_b32 v22, v1 offset:13312
s_waitcnt lgkmcnt(0)
s_mov_b64 exec, s[28:29]
buffer_store_dword v10, v3, s[20:23], s40 offen
s_mov_b64 exec, s[28:29]
buffer_store_dword v11, v3, s[20:23], s41 offen
s_mov_b64 exec, s[28:29]
buffer_store_dword v12, v3, s[20:23], s42 offen
s_mov_b64 exec, s[28:29]
buffer_store_dword v13, v3, s[20:23], s43 offen
s_mov_b64 exec, s[28:29]
buffer_store_dword v14, v3, s[20:23], s44 offen
s_mov_b64 exec, s[28:29]
buffer_store_dword v15, v3, s[20:23], s45 offen
s_mov_b64 exec, s[28:29]
buffer_store_dword v16, v3, s[20:23], s46 offen
s_mov_b64 exec, s[28:29]
buffer_store_dword v17, v3, s[20:23], s47 offen
s_mov_b64 exec, s[28:29]
buffer_store_dword v18, v3, s[20:23], s48 offen
s_mov_b64 exec, s[28:29]
buffer_store_dword v19, v3, s[20:23], s49 offen
s_mov_b64 exec, s[28:29]
buffer_store_dword v20, v3, s[20:23], s50 offen
s_mov_b64 exec, s[28:29]
buffer_store_dword v21, v3, s[20:23], s51 offen
s_mov_b64 exec, vcc
buffer_store_dword v22, v3, s[20:23], s52 offen
L1end:
s_endpgm
.globl standalone__kernel_systems_refs_featgraph__graph_kernel
.p2align 8
.type standalone__kernel_systems_refs_featgraph__graph_kernel,@function
standalone__kernel_systems_refs_featgraph__graph_kernel:
s_cmp_ge_u32 s2, 256
s_cbranch_scc1 L2end
s_load_dwordx2 s[4:5], s[0:1], 0
s_load_dwordx4 s[8:11], s[0:1], 24
s_load_dwordx2 s[12:13], s[0:1], 40
s_load_dwordx2 s[14:15], s[0:1], 56
s_waitcnt lgkmcnt(0)
s_mov_b32 s16, s4
s_mov_b32 s17, s5
s_mov_b32 s18, 6400000
s_mov_b32 s19, 0x20000
s_mov_b32 s20, s8
s_mov_b32 s21, s9
s_mov_b32 s22, 8192
s_mov_b32 s23, 0x20000
s_mov_b32 s24, s10
s_mov_b32 s25, s11
s_mov_b32 s26, 8192
s_mov_b32 s27, 0x20000
s_mov_b32 s28, s12
s_mov_b32 s29, s13
s_mov_b32 s30, 6400000
s_mov_b32 s31, 0x20000
s_mov_b32 s32, s14
s_mov_b32 s33, s15
s_mov_b32 s34, 4456448
s_mov_b32 s35, 0x20000
v_and_b32 v1, 63, v0
v_lshrrev_b32 v2, 6, v0
s_nop 0
v_readfirstlane_b32 s36, v2
s_mul_i32 s37, s2, 25088
v_lshlrev_b32 v3, 4, v0
v_add_u32 v3, 75776, v3
v_mov_b32 v4, 0
v_mov_b32 v5, 0
v_mov_b32 v6, 0
v_mov_b32 v7, 0
ds_write_b128 v3, v[4:7] offset:0
ds_write_b128 v3, v[4:7] offset:16384
ds_write_b128 v3, v[4:7] offset:32768
v_cmp_gt_u32 vcc, 256, v0
s_and_saveexec_b64 s[38:39], vcc
ds_write_b128 v3, v[4:7] offset:49152
s_mov_b64 exec, s[38:39]
v_cmp_gt_u32 vcc, 256, v0
s_and_saveexec_b64 s[38:39], vcc
s_lshl_b32 s40, s2, 10
s_add_u32 s40, s40, 4194304
v_lshlrev_b32 v8, 2, v0
buffer_load_dword v9, v8, s[32:35], s40 offen
s_waitcnt vmcnt(0)
v_lshrrev_b32 v10, 16, v9
v_mov_b32 v11, v10
s_mov_b64 exec, s[38:39]
s_and_saveexec_b64 s[38:39], vcc
ds_write_b32 v8, v11 offset:4
s_mov_b64 exec, s[38:39]
s_waitcnt lgkmcnt(0)
s_barrier
s_and_saveexec_b64 s[38:39], vcc
v_subrev_u32 v12, 4, v8
v_max_i32 v12, 0, v12
ds_read_b32 v12, v12 offset:4
v_mov_b32 v33, 1
v_cmp_le_u32 s[42:43], v33, v0
s_nop 1
s_waitcnt lgkmcnt(0)
v_cndmask_b32 v12, 0, v12, s[42:43]
v_add_u32 v11, v11, v12
s_mov_b64 exec, s[38:39]
s_barrier
s_and_saveexec_b64 s[38:39], vcc
ds_write_b32 v8, v11 offset:4
s_mov_b64 exec, s[38:39]
s_waitcnt lgkmcnt(0)
s_barrier
s_and_saveexec_b64 s[38:39], vcc
v_subrev_u32 v12, 8, v8
v_max_i32 v12, 0, v12
ds_read_b32 v12, v12 offset:4
v_mov_b32 v33, 2
v_cmp_le_u32 s[42:43], v33, v0
s_nop 1
s_waitcnt lgkmcnt(0)
v_cndmask_b32 v12, 0, v12, s[42:43]
v_add_u32 v11, v11, v12
s_mov_b64 exec, s[38:39]
s_barrier
s_and_saveexec_b64 s[38:39], vcc
ds_write_b32 v8, v11 offset:4
s_mov_b64 exec, s[38:39]
s_waitcnt lgkmcnt(0)
s_barrier
s_and_saveexec_b64 s[38:39], vcc
v_subrev_u32 v12, 16, v8
v_max_i32 v12, 0, v12
ds_read_b32 v12, v12 offset:4
v_mov_b32 v33, 4
v_cmp_le_u32 s[42:43], v33, v0
s_nop 1
s_waitcnt lgkmcnt(0)
v_cndmask_b32 v12, 0, v12, s[42:43]
v_add_u32 v11, v11, v12
s_mov_b64 exec, s[38:39]
s_barrier
s_and_saveexec_b64 s[38:39], vcc
ds_write_b32 v8, v11 offset:4
s_mov_b64 exec, s[38:39]
s_waitcnt lgkmcnt(0)
s_barrier
s_and_saveexec_b64 s[38:39], vcc
v_subrev_u32 v12, 32, v8
v_max_i32 v12, 0, v12
ds_read_b32 v12, v12 offset:4
v_mov_b32 v33, 8
v_cmp_le_u32 s[42:43], v33, v0
s_nop 1
s_waitcnt lgkmcnt(0)
v_cndmask_b32 v12, 0, v12, s[42:43]
v_add_u32 v11, v11, v12
s_mov_b64 exec, s[38:39]
s_barrier
s_and_saveexec_b64 s[38:39], vcc
ds_write_b32 v8, v11 offset:4
s_mov_b64 exec, s[38:39]
s_waitcnt lgkmcnt(0)
s_barrier
s_and_saveexec_b64 s[38:39], vcc
v_subrev_u32 v12, 64, v8
v_max_i32 v12, 0, v12
ds_read_b32 v12, v12 offset:4
v_mov_b32 v33, 16
v_cmp_le_u32 s[42:43], v33, v0
s_nop 1
s_waitcnt lgkmcnt(0)
v_cndmask_b32 v12, 0, v12, s[42:43]
v_add_u32 v11, v11, v12
s_mov_b64 exec, s[38:39]
s_barrier
s_and_saveexec_b64 s[38:39], vcc
ds_write_b32 v8, v11 offset:4
s_mov_b64 exec, s[38:39]
s_waitcnt lgkmcnt(0)
s_barrier
s_and_saveexec_b64 s[38:39], vcc
v_subrev_u32 v12, 128, v8
v_max_i32 v12, 0, v12
ds_read_b32 v12, v12 offset:4
v_mov_b32 v33, 32
v_cmp_le_u32 s[42:43], v33, v0
s_nop 1
s_waitcnt lgkmcnt(0)
v_cndmask_b32 v12, 0, v12, s[42:43]
v_add_u32 v11, v11, v12
s_mov_b64 exec, s[38:39]
s_barrier
s_and_saveexec_b64 s[38:39], vcc
ds_write_b32 v8, v11 offset:4
s_mov_b64 exec, s[38:39]
s_waitcnt lgkmcnt(0)
s_barrier
s_and_saveexec_b64 s[38:39], vcc
v_subrev_u32 v12, 256, v8
v_max_i32 v12, 0, v12
ds_read_b32 v12, v12 offset:4
v_mov_b32 v33, 64
v_cmp_le_u32 s[42:43], v33, v0
s_nop 1
s_waitcnt lgkmcnt(0)
v_cndmask_b32 v12, 0, v12, s[42:43]
v_add_u32 v11, v11, v12
s_mov_b64 exec, s[38:39]
s_barrier
s_and_saveexec_b64 s[38:39], vcc
ds_write_b32 v8, v11 offset:4
s_mov_b64 exec, s[38:39]
s_waitcnt lgkmcnt(0)
s_barrier
s_and_saveexec_b64 s[38:39], vcc
v_subrev_u32 v12, 512, v8
v_max_i32 v12, 0, v12
ds_read_b32 v12, v12 offset:4
v_mov_b32 v33, 128
v_cmp_le_u32 s[42:43], v33, v0
s_nop 1
s_waitcnt lgkmcnt(0)
v_cndmask_b32 v12, 0, v12, s[42:43]
v_add_u32 v11, v11, v12
s_mov_b64 exec, s[38:39]
s_barrier
s_and_saveexec_b64 s[38:39], vcc
ds_write_b32 v8, v11 offset:4
ds_write_b32 v8, v9 offset:2048
s_mov_b64 exec, s[38:39]
v_mov_b32 v12, 0
ds_write_b32 v12, v12 offset:0
v_and_b32 v13, 15, v1
v_lshrrev_b32 v14, 4, v1
v_lshlrev_b32 v15, 1, v13
v_lshl_add_u32 v15, v14, 10, v15
v_add_u32 v19, 0x1000, v15
s_cmp_ge_u32 s36, 13
s_cbranch_scc1 LQskip
buffer_load_ushort v80, v15, s[20:23], 0 offen offset:0
buffer_load_ushort v81, v15, s[20:23], 0 offen offset:128
buffer_load_ushort v82, v15, s[20:23], 0 offen offset:256
buffer_load_ushort v83, v15, s[20:23], 0 offen offset:384
buffer_load_ushort v84, v15, s[20:23], 0 offen offset:512
buffer_load_ushort v85, v15, s[20:23], 0 offen offset:640
buffer_load_ushort v86, v15, s[20:23], 0 offen offset:768
buffer_load_ushort v87, v15, s[20:23], 0 offen offset:896
s_waitcnt vmcnt(0)
v_lshl_or_b32 v40, v81, 16, v80
v_lshl_or_b32 v41, v83, 16, v82
v_lshl_or_b32 v42, v85, 16, v84
v_lshl_or_b32 v43, v87, 16, v86
buffer_load_ushort v80, v19, s[20:23], 0 offen offset:0
buffer_load_ushort v81, v19, s[20:23], 0 offen offset:128
buffer_load_ushort v82, v19, s[20:23], 0 offen offset:256
buffer_load_ushort v83, v19, s[20:23], 0 offen offset:384
buffer_load_ushort v84, v19, s[20:23], 0 offen offset:512
buffer_load_ushort v85, v19, s[20:23], 0 offen offset:640
buffer_load_ushort v86, v19, s[20:23], 0 offen offset:768
buffer_load_ushort v87, v19, s[20:23], 0 offen offset:896
s_waitcnt vmcnt(0)
v_lshl_or_b32 v44, v81, 16, v80
v_lshl_or_b32 v45, v83, 16, v82
v_lshl_or_b32 v46, v85, 16, v84
v_lshl_or_b32 v47, v87, 16, v86
buffer_load_ushort v80, v15, s[20:23], 0 offen offset:32
buffer_load_ushort v81, v15, s[20:23], 0 offen offset:160
buffer_load_ushort v82, v15, s[20:23], 0 offen offset:288
buffer_load_ushort v83, v15, s[20:23], 0 offen offset:416
buffer_load_ushort v84, v15, s[20:23], 0 offen offset:544
buffer_load_ushort v85, v15, s[20:23], 0 offen offset:672
buffer_load_ushort v86, v15, s[20:23], 0 offen offset:800
buffer_load_ushort v87, v15, s[20:23], 0 offen offset:928
s_waitcnt vmcnt(0)
v_lshl_or_b32 v48, v81, 16, v80
v_lshl_or_b32 v49, v83, 16, v82
v_lshl_or_b32 v50, v85, 16, v84
v_lshl_or_b32 v51, v87, 16, v86
buffer_load_ushort v80, v19, s[20:23], 0 offen offset:32
buffer_load_ushort v81, v19, s[20:23], 0 offen offset:160
buffer_load_ushort v82, v19, s[20:23], 0 offen offset:288
buffer_load_ushort v83, v19, s[20:23], 0 offen offset:416
buffer_load_ushort v84, v19, s[20:23], 0 offen offset:544
buffer_load_ushort v85, v19, s[20:23], 0 offen offset:672
buffer_load_ushort v86, v19, s[20:23], 0 offen offset:800
buffer_load_ushort v87, v19, s[20:23], 0 offen offset:928
s_waitcnt vmcnt(0)
v_lshl_or_b32 v52, v81, 16, v80
v_lshl_or_b32 v53, v83, 16, v82
v_lshl_or_b32 v54, v85, 16, v84
v_lshl_or_b32 v55, v87, 16, v86
buffer_load_ushort v80, v15, s[20:23], 0 offen offset:64
buffer_load_ushort v81, v15, s[20:23], 0 offen offset:192
buffer_load_ushort v82, v15, s[20:23], 0 offen offset:320
buffer_load_ushort v83, v15, s[20:23], 0 offen offset:448
buffer_load_ushort v84, v15, s[20:23], 0 offen offset:576
buffer_load_ushort v85, v15, s[20:23], 0 offen offset:704
buffer_load_ushort v86, v15, s[20:23], 0 offen offset:832
buffer_load_ushort v87, v15, s[20:23], 0 offen offset:960
s_waitcnt vmcnt(0)
v_lshl_or_b32 v56, v81, 16, v80
v_lshl_or_b32 v57, v83, 16, v82
v_lshl_or_b32 v58, v85, 16, v84
v_lshl_or_b32 v59, v87, 16, v86
buffer_load_ushort v80, v19, s[20:23], 0 offen offset:64
buffer_load_ushort v81, v19, s[20:23], 0 offen offset:192
buffer_load_ushort v82, v19, s[20:23], 0 offen offset:320
buffer_load_ushort v83, v19, s[20:23], 0 offen offset:448
buffer_load_ushort v84, v19, s[20:23], 0 offen offset:576
buffer_load_ushort v85, v19, s[20:23], 0 offen offset:704
buffer_load_ushort v86, v19, s[20:23], 0 offen offset:832
buffer_load_ushort v87, v19, s[20:23], 0 offen offset:960
s_waitcnt vmcnt(0)
v_lshl_or_b32 v60, v81, 16, v80
v_lshl_or_b32 v61, v83, 16, v82
v_lshl_or_b32 v62, v85, 16, v84
v_lshl_or_b32 v63, v87, 16, v86
buffer_load_ushort v80, v15, s[20:23], 0 offen offset:96
buffer_load_ushort v81, v15, s[20:23], 0 offen offset:224
buffer_load_ushort v82, v15, s[20:23], 0 offen offset:352
buffer_load_ushort v83, v15, s[20:23], 0 offen offset:480
buffer_load_ushort v84, v15, s[20:23], 0 offen offset:608
buffer_load_ushort v85, v15, s[20:23], 0 offen offset:736
buffer_load_ushort v86, v15, s[20:23], 0 offen offset:864
buffer_load_ushort v87, v15, s[20:23], 0 offen offset:992
s_waitcnt vmcnt(0)
v_lshl_or_b32 v64, v81, 16, v80
v_lshl_or_b32 v65, v83, 16, v82
v_lshl_or_b32 v66, v85, 16, v84
v_lshl_or_b32 v67, v87, 16, v86
buffer_load_ushort v80, v19, s[20:23], 0 offen offset:96
buffer_load_ushort v81, v19, s[20:23], 0 offen offset:224
buffer_load_ushort v82, v19, s[20:23], 0 offen offset:352
buffer_load_ushort v83, v19, s[20:23], 0 offen offset:480
buffer_load_ushort v84, v19, s[20:23], 0 offen offset:608
buffer_load_ushort v85, v19, s[20:23], 0 offen offset:736
buffer_load_ushort v86, v19, s[20:23], 0 offen offset:864
buffer_load_ushort v87, v19, s[20:23], 0 offen offset:992
s_waitcnt vmcnt(0)
v_lshl_or_b32 v68, v81, 16, v80
v_lshl_or_b32 v69, v83, 16, v82
v_lshl_or_b32 v70, v85, 16, v84
v_lshl_or_b32 v71, v87, 16, v86
s_lshl_b32 s40, s36, 11
s_add_u32 s40, s40, s37
v_lshlrev_b32 v16, 7, v13
v_lshl_add_u32 v16, v14, 4, v16
buffer_load_dwordx4 v[72:75], v16, s[16:19], s40 offen
buffer_load_dwordx4 v[76:79], v16, s[16:19], s40 offen offset:64
s_waitcnt vmcnt(0)
s_lshl_b32 s40, s36, 11
v_lshlrev_b32 v17, 9, v14
v_lshl_add_u32 v17, v13, 1, v17
v_add_u32 v17, s40, v17
v_mfma_f32_16x16x32_bf16 v[84:87], v[72:75], v[40:43], 0
v_mfma_f32_16x16x32_bf16 v[84:87], v[76:79], v[44:47], v[84:87]
s_nop 7
v_cvt_pk_bf16_f32 v84, v84, v85
v_cvt_pk_bf16_f32 v86, v86, v87
ds_write_b16 v17, v84 offset:49152
ds_write_b16_d16_hi v17, v84 offset:49280
ds_write_b16 v17, v86 offset:49408
ds_write_b16_d16_hi v17, v86 offset:49536
v_mfma_f32_16x16x32_bf16 v[84:87], v[72:75], v[48:51], 0
v_mfma_f32_16x16x32_bf16 v[84:87], v[76:79], v[52:55], v[84:87]
s_nop 7
v_cvt_pk_bf16_f32 v84, v84, v85
v_cvt_pk_bf16_f32 v86, v86, v87
ds_write_b16 v17, v84 offset:49184
ds_write_b16_d16_hi v17, v84 offset:49312
ds_write_b16 v17, v86 offset:49440
ds_write_b16_d16_hi v17, v86 offset:49568
v_mfma_f32_16x16x32_bf16 v[84:87], v[72:75], v[56:59], 0
v_mfma_f32_16x16x32_bf16 v[84:87], v[76:79], v[60:63], v[84:87]
s_nop 7
v_cvt_pk_bf16_f32 v84, v84, v85
v_cvt_pk_bf16_f32 v86, v86, v87
ds_write_b16 v17, v84 offset:49216
ds_write_b16_d16_hi v17, v84 offset:49344
ds_write_b16 v17, v86 offset:49472
ds_write_b16_d16_hi v17, v86 offset:49600
v_mfma_f32_16x16x32_bf16 v[84:87], v[72:75], v[64:67], 0
v_mfma_f32_16x16x32_bf16 v[84:87], v[76:79], v[68:71], v[84:87]
s_nop 7
v_cvt_pk_bf16_f32 v84, v84, v85
v_cvt_pk_bf16_f32 v86, v86, v87
ds_write_b16 v17, v84 offset:49248
ds_write_b16_d16_hi v17, v84 offset:49376
ds_write_b16 v17, v86 offset:49504
ds_write_b16_d16_hi v17, v86 offset:49632
LQskip:
s_waitcnt lgkmcnt(0)
s_barrier
v_mov_b32 v20, 1024
ds_read_b32 v20, v20
v_lshrrev_b32 v21, 2, v0
v_lshlrev_b32 v21, 2, v21
ds_read_b32 v22, v21 offset:0
ds_read_b32 v23, v21 offset:4
ds_read_b32 v24, v21 offset:2048
s_waitcnt lgkmcnt(0)
v_readfirstlane_b32 s44, v20
s_mov_b32 s45, 0
v_and_b32 v24, 0xffff, v24
v_mul_u32_u24 v25, 3125, v21
v_sub_u32 v24, v24, v22
v_lshl_add_u32 v24, v24, 2, v25
v_and_b32 v26, 3, v0
v_add_u32 v26, v26, v22
v_lshrrev_b32 v27, 3, v1
v_and_b32 v28, 7, v1
v_lshlrev_b32 v28, 4, v28
v_lshl_add_u32 v27, s36, 3, v27
s_mov_b32 s48, 0x3e38aa3b
v_lshlrev_b32 v8, 2, v0
v_mov_b32 v34, 1
LROUND:
s_cmp_ge_u32 s45, s44
s_cbranch_scc1 LEPI
s_add_u32 s46, s45, 4096
v_min_u32 v29, s46, v23
v_mov_b32 v12, 0
v_cmp_gt_u32 vcc, 256, v0
s_and_saveexec_b64 s[38:39], vcc
ds_write_b32 v8, v12 offset:4096
s_mov_b64 exec, s[38:39]
s_waitcnt lgkmcnt(0)
s_barrier
LCOPY:
v_cmp_lt_u32 vcc, v26, v29
s_and_saveexec_b64 s[38:39], vcc
s_cbranch_execz LCDONE
v_lshl_add_u32 v30, v26, 2, v24
buffer_load_dword v31, v30, s[32:35], 0 offen
v_subrev_u32 v32, s45, v26
v_lshlrev_b32 v32, 2, v32
v_add_u32 v26, 4, v26
s_waitcnt vmcnt(0)
v_lshrrev_b32 v33, 14, v31
v_and_b32 v33, 0x3fc, v33
ds_add_rtn_u32 v33, v33, v34 offset:4096
ds_write_b32 v32, v31 offset:8192
s_waitcnt lgkmcnt(0)
ds_write_b32 v32, v33 offset:24576
s_mov_b64 exec, s[38:39]
s_branch LCOPY
LCDONE:
s_mov_b64 exec, s[38:39]
s_waitcnt lgkmcnt(0)
s_barrier
s_min_u32 s47, s46, s44
s_sub_u32 s47, s47, s45
v_cmp_gt_u32 vcc, 256, v0
s_and_saveexec_b64 s[38:39], vcc
ds_read_b32 v11, v8 offset:4096
s_mov_b64 exec, s[38:39]
s_waitcnt lgkmcnt(0)
s_barrier
s_and_saveexec_b64 s[38:39], vcc
ds_write_b32 v8, v11 offset:4100
s_mov_b64 exec, s[38:39]
s_waitcnt lgkmcnt(0)
s_barrier
s_and_saveexec_b64 s[38:39], vcc
v_subrev_u32 v12, 4, v8
v_max_i32 v12, 0, v12
ds_read_b32 v12, v12 offset:4100
v_mov_b32 v33, 1
v_cmp_le_u32 s[42:43], v33, v0
s_waitcnt lgkmcnt(0)
s_nop 1
v_cndmask_b32 v12, 0, v12, s[42:43]
v_add_u32 v11, v11, v12
s_mov_b64 exec, s[38:39]
s_barrier
s_and_saveexec_b64 s[38:39], vcc
ds_write_b32 v8, v11 offset:4100
s_mov_b64 exec, s[38:39]
s_waitcnt lgkmcnt(0)
s_barrier
s_and_saveexec_b64 s[38:39], vcc
v_subrev_u32 v12, 8, v8
v_max_i32 v12, 0, v12
ds_read_b32 v12, v12 offset:4100
v_mov_b32 v33, 2
v_cmp_le_u32 s[42:43], v33, v0
s_waitcnt lgkmcnt(0)
s_nop 1
v_cndmask_b32 v12, 0, v12, s[42:43]
v_add_u32 v11, v11, v12
s_mov_b64 exec, s[38:39]
s_barrier
s_and_saveexec_b64 s[38:39], vcc
ds_write_b32 v8, v11 offset:4100
s_mov_b64 exec, s[38:39]
s_waitcnt lgkmcnt(0)
s_barrier
s_and_saveexec_b64 s[38:39], vcc
v_subrev_u32 v12, 16, v8
v_max_i32 v12, 0, v12
ds_read_b32 v12, v12 offset:4100
v_mov_b32 v33, 4
v_cmp_le_u32 s[42:43], v33, v0
s_waitcnt lgkmcnt(0)
s_nop 1
v_cndmask_b32 v12, 0, v12, s[42:43]
v_add_u32 v11, v11, v12
s_mov_b64 exec, s[38:39]
s_barrier
s_and_saveexec_b64 s[38:39], vcc
ds_write_b32 v8, v11 offset:4100
s_mov_b64 exec, s[38:39]
s_waitcnt lgkmcnt(0)
s_barrier
s_and_saveexec_b64 s[38:39], vcc
v_subrev_u32 v12, 32, v8
v_max_i32 v12, 0, v12
ds_read_b32 v12, v12 offset:4100
v_mov_b32 v33, 8
v_cmp_le_u32 s[42:43], v33, v0
s_waitcnt lgkmcnt(0)
s_nop 1
v_cndmask_b32 v12, 0, v12, s[42:43]
v_add_u32 v11, v11, v12
s_mov_b64 exec, s[38:39]
s_barrier
s_and_saveexec_b64 s[38:39], vcc
ds_write_b32 v8, v11 offset:4100
s_mov_b64 exec, s[38:39]
s_waitcnt lgkmcnt(0)
s_barrier
s_and_saveexec_b64 s[38:39], vcc
v_subrev_u32 v12, 64, v8
v_max_i32 v12, 0, v12
ds_read_b32 v12, v12 offset:4100
v_mov_b32 v33, 16
v_cmp_le_u32 s[42:43], v33, v0
s_waitcnt lgkmcnt(0)
s_nop 1
v_cndmask_b32 v12, 0, v12, s[42:43]
v_add_u32 v11, v11, v12
s_mov_b64 exec, s[38:39]
s_barrier
s_and_saveexec_b64 s[38:39], vcc
ds_write_b32 v8, v11 offset:4100
s_mov_b64 exec, s[38:39]
s_waitcnt lgkmcnt(0)
s_barrier
s_and_saveexec_b64 s[38:39], vcc
v_subrev_u32 v12, 128, v8
v_max_i32 v12, 0, v12
ds_read_b32 v12, v12 offset:4100
v_mov_b32 v33, 32
v_cmp_le_u32 s[42:43], v33, v0
s_waitcnt lgkmcnt(0)
s_nop 1
v_cndmask_b32 v12, 0, v12, s[42:43]
v_add_u32 v11, v11, v12
s_mov_b64 exec, s[38:39]
s_barrier
s_and_saveexec_b64 s[38:39], vcc
ds_write_b32 v8, v11 offset:4100
s_mov_b64 exec, s[38:39]
s_waitcnt lgkmcnt(0)
s_barrier
s_and_saveexec_b64 s[38:39], vcc
v_subrev_u32 v12, 256, v8
v_max_i32 v12, 0, v12
ds_read_b32 v12, v12 offset:4100
v_mov_b32 v33, 64
v_cmp_le_u32 s[42:43], v33, v0
s_waitcnt lgkmcnt(0)
s_nop 1
v_cndmask_b32 v12, 0, v12, s[42:43]
v_add_u32 v11, v11, v12
s_mov_b64 exec, s[38:39]
s_barrier
s_and_saveexec_b64 s[38:39], vcc
ds_write_b32 v8, v11 offset:4100
s_mov_b64 exec, s[38:39]
s_waitcnt lgkmcnt(0)
s_barrier
s_and_saveexec_b64 s[38:39], vcc
v_subrev_u32 v12, 512, v8
v_max_i32 v12, 0, v12
ds_read_b32 v12, v12 offset:4100
v_mov_b32 v33, 128
v_cmp_le_u32 s[42:43], v33, v0
s_waitcnt lgkmcnt(0)
s_nop 1
v_cndmask_b32 v12, 0, v12, s[42:43]
v_add_u32 v11, v11, v12
s_mov_b64 exec, s[38:39]
s_barrier
s_and_saveexec_b64 s[38:39], vcc
ds_write_b32 v8, v11 offset:4100
s_mov_b64 exec, s[38:39]
v_mov_b32 v12, 0
ds_write_b32 v12, v12 offset:4096
s_waitcnt lgkmcnt(0)
s_barrier
v_mov_b32 v35, v0
LSC:
v_cmp_gt_u32 vcc, s47, v35
s_and_saveexec_b64 s[38:39], vcc
s_cbranch_execz LSCD
v_lshlrev_b32 v32, 2, v35
ds_read_b32 v31, v32 offset:8192
ds_read_b32 v33, v32 offset:24576
v_add_u32 v35, 0x400, v35
s_waitcnt lgkmcnt(1)
v_lshrrev_b32 v32, 14, v31
v_and_b32 v32, 0x3fc, v32
ds_read_b32 v32, v32 offset:4096
s_waitcnt lgkmcnt(0)
v_add_u32 v32, v32, v33
v_lshlrev_b32 v32, 1, v32
ds_write_b16 v32, v31 offset:40960
s_mov_b64 exec, s[38:39]
s_branch LSC
LSCD:
s_mov_b64 exec, s[38:39]
s_waitcnt lgkmcnt(0)
s_barrier
v_mov_b32 v36, v27
LNODE:
v_lshlrev_b32 v37, 2, v36
ds_read_b32 v38, v37 offset:4096
ds_read_b32 v39, v37 offset:4100
v_lshl_add_u32 v37, v36, 7, v28
ds_read_b128 v[60:63], v37 offset:49152
v_mov_b32 v64, 0
v_mov_b32 v65, 0
v_mov_b32 v66, 0
v_mov_b32 v67, 0
v_mov_b32 v68, 0
v_mov_b32 v69, 0
v_mov_b32 v70, 0
v_mov_b32 v71, 0
s_waitcnt lgkmcnt(0)
LEDGE:
v_cmp_lt_u32 vcc, v38, v39
s_cbranch_vccz LEDONE
v_add_u32 v100, 0, v38
v_cmp_lt_u32 s[50:51], v100, v39
v_lshlrev_b32 v100, 1, v100
ds_read_u16 v100, v100 offset:40960
v_add_u32 v101, 1, v38
v_cmp_lt_u32 s[52:53], v101, v39
v_lshlrev_b32 v101, 1, v101
ds_read_u16 v101, v101 offset:40960
v_add_u32 v102, 2, v38
v_cmp_lt_u32 s[54:55], v102, v39
v_lshlrev_b32 v102, 1, v102
ds_read_u16 v102, v102 offset:40960
v_add_u32 v103, 3, v38
v_cmp_lt_u32 s[56:57], v103, v39
v_lshlrev_b32 v103, 1, v103
ds_read_u16 v103, v103 offset:40960
v_add_u32 v38, 4, v38
s_waitcnt lgkmcnt(0)
v_cndmask_b32 v100, 0, v100, s[50:51]
v_lshl_add_u32 v104, v100, 7, v28
buffer_load_dwordx4 v[40:43], v104, s[16:19], 0 offen
v_cndmask_b32 v101, 0, v101, s[52:53]
v_lshl_add_u32 v105, v101, 7, v28
buffer_load_dwordx4 v[44:47], v105, s[16:19], 0 offen
v_cndmask_b32 v102, 0, v102, s[54:55]
v_lshl_add_u32 v106, v102, 7, v28
buffer_load_dwordx4 v[48:51], v106, s[16:19], 0 offen
v_cndmask_b32 v103, 0, v103, s[56:57]
v_lshl_add_u32 v107, v103, 7, v28
buffer_load_dwordx4 v[52:55], v107, s[16:19], 0 offen
s_waitcnt vmcnt(3)
v_mov_b32 v112, 0
v_dot2_f32_bf16 v112, v40, v60, v112
v_dot2_f32_bf16 v112, v41, v61, v112
v_dot2_f32_bf16 v112, v42, v62, v112
v_dot2_f32_bf16 v112, v43, v63, v112
s_nop 3
v_add_f32_dpp v112, v112, v112 quad_perm:[1,0,3,2] row_mask:0xf bank_mask:0xf
s_nop 1
v_add_f32_dpp v112, v112, v112 quad_perm:[2,3,0,1] row_mask:0xf bank_mask:0xf
s_nop 1
v_add_f32_dpp v112, v112, v112 row_half_mirror row_mask:0xf bank_mask:0xf
v_mul_f32 v112, s48, v112
v_sub_f32 v112, 0, v112
v_exp_f32 v112, v112
s_nop 0
v_add_f32 v112, 1.0, v112
v_rcp_f32 v112, v112
s_nop 0
v_cndmask_b32 v112, 0, v112, s[50:51]
v_lshlrev_b32 v116, 16, v40
v_and_b32 v117, 0xffff0000, v40
v_fmac_f32 v64, v116, v112
v_fmac_f32 v65, v117, v112
v_lshlrev_b32 v116, 16, v41
v_and_b32 v117, 0xffff0000, v41
v_fmac_f32 v66, v116, v112
v_fmac_f32 v67, v117, v112
v_lshlrev_b32 v116, 16, v42
v_and_b32 v117, 0xffff0000, v42
v_fmac_f32 v68, v116, v112
v_fmac_f32 v69, v117, v112
v_lshlrev_b32 v116, 16, v43
v_and_b32 v117, 0xffff0000, v43
v_fmac_f32 v70, v116, v112
v_fmac_f32 v71, v117, v112
s_waitcnt vmcnt(2)
v_mov_b32 v113, 0
v_dot2_f32_bf16 v113, v44, v60, v113
v_dot2_f32_bf16 v113, v45, v61, v113
v_dot2_f32_bf16 v113, v46, v62, v113
v_dot2_f32_bf16 v113, v47, v63, v113
s_nop 3
v_add_f32_dpp v113, v113, v113 quad_perm:[1,0,3,2] row_mask:0xf bank_mask:0xf
s_nop 1
v_add_f32_dpp v113, v113, v113 quad_perm:[2,3,0,1] row_mask:0xf bank_mask:0xf
s_nop 1
v_add_f32_dpp v113, v113, v113 row_half_mirror row_mask:0xf bank_mask:0xf
v_mul_f32 v113, s48, v113
v_sub_f32 v113, 0, v113
v_exp_f32 v113, v113
s_nop 0
v_add_f32 v113, 1.0, v113
v_rcp_f32 v113, v113
s_nop 0
v_cndmask_b32 v113, 0, v113, s[52:53]
v_lshlrev_b32 v116, 16, v44
v_and_b32 v117, 0xffff0000, v44
v_fmac_f32 v64, v116, v113
v_fmac_f32 v65, v117, v113
v_lshlrev_b32 v116, 16, v45
v_and_b32 v117, 0xffff0000, v45
v_fmac_f32 v66, v116, v113
v_fmac_f32 v67, v117, v113
v_lshlrev_b32 v116, 16, v46
v_and_b32 v117, 0xffff0000, v46
v_fmac_f32 v68, v116, v113
v_fmac_f32 v69, v117, v113
v_lshlrev_b32 v116, 16, v47
v_and_b32 v117, 0xffff0000, v47
v_fmac_f32 v70, v116, v113
v_fmac_f32 v71, v117, v113
s_waitcnt vmcnt(1)
v_mov_b32 v114, 0
v_dot2_f32_bf16 v114, v48, v60, v114
v_dot2_f32_bf16 v114, v49, v61, v114
v_dot2_f32_bf16 v114, v50, v62, v114
v_dot2_f32_bf16 v114, v51, v63, v114
s_nop 3
v_add_f32_dpp v114, v114, v114 quad_perm:[1,0,3,2] row_mask:0xf bank_mask:0xf
s_nop 1
v_add_f32_dpp v114, v114, v114 quad_perm:[2,3,0,1] row_mask:0xf bank_mask:0xf
s_nop 1
v_add_f32_dpp v114, v114, v114 row_half_mirror row_mask:0xf bank_mask:0xf
v_mul_f32 v114, s48, v114
v_sub_f32 v114, 0, v114
v_exp_f32 v114, v114
s_nop 0
v_add_f32 v114, 1.0, v114
v_rcp_f32 v114, v114
s_nop 0
v_cndmask_b32 v114, 0, v114, s[54:55]
v_lshlrev_b32 v116, 16, v48
v_and_b32 v117, 0xffff0000, v48
v_fmac_f32 v64, v116, v114
v_fmac_f32 v65, v117, v114
v_lshlrev_b32 v116, 16, v49
v_and_b32 v117, 0xffff0000, v49
v_fmac_f32 v66, v116, v114
v_fmac_f32 v67, v117, v114
v_lshlrev_b32 v116, 16, v50
v_and_b32 v117, 0xffff0000, v50
v_fmac_f32 v68, v116, v114
v_fmac_f32 v69, v117, v114
v_lshlrev_b32 v116, 16, v51
v_and_b32 v117, 0xffff0000, v51
v_fmac_f32 v70, v116, v114
v_fmac_f32 v71, v117, v114
s_waitcnt vmcnt(0)
v_mov_b32 v115, 0
v_dot2_f32_bf16 v115, v52, v60, v115
v_dot2_f32_bf16 v115, v53, v61, v115
v_dot2_f32_bf16 v115, v54, v62, v115
v_dot2_f32_bf16 v115, v55, v63, v115
s_nop 3
v_add_f32_dpp v115, v115, v115 quad_perm:[1,0,3,2] row_mask:0xf bank_mask:0xf
s_nop 1
v_add_f32_dpp v115, v115, v115 quad_perm:[2,3,0,1] row_mask:0xf bank_mask:0xf
s_nop 1
v_add_f32_dpp v115, v115, v115 row_half_mirror row_mask:0xf bank_mask:0xf
v_mul_f32 v115, s48, v115
v_sub_f32 v115, 0, v115
v_exp_f32 v115, v115
s_nop 0
v_add_f32 v115, 1.0, v115
v_rcp_f32 v115, v115
s_nop 0
v_cndmask_b32 v115, 0, v115, s[56:57]
v_lshlrev_b32 v116, 16, v52
v_and_b32 v117, 0xffff0000, v52
v_fmac_f32 v64, v116, v115
v_fmac_f32 v65, v117, v115
v_lshlrev_b32 v116, 16, v53
v_and_b32 v117, 0xffff0000, v53
v_fmac_f32 v66, v116, v115
v_fmac_f32 v67, v117, v115
v_lshlrev_b32 v116, 16, v54
v_and_b32 v117, 0xffff0000, v54
v_fmac_f32 v68, v116, v115
v_fmac_f32 v69, v117, v115
v_lshlrev_b32 v116, 16, v55
v_and_b32 v117, 0xffff0000, v55
v_fmac_f32 v70, v116, v115
v_fmac_f32 v71, v117, v115
s_branch LEDGE
LEDONE:
v_lshlrev_b32 v37, 1, v37
v_add_u32 v37, 75776, v37
ds_read_b128 v[40:43], v37
ds_read_b128 v[44:47], v37 offset:16
s_waitcnt lgkmcnt(0)
v_add_f32 v64, v64, v40
v_add_f32 v65, v65, v41
v_add_f32 v66, v66, v42
v_add_f32 v67, v67, v43
v_add_f32 v68, v68, v44
v_add_f32 v69, v69, v45
v_add_f32 v70, v70, v46
v_add_f32 v71, v71, v47
ds_write_b128 v37, v[64:67]
ds_write_b128 v37, v[68:71] offset:16
v_add_u32 v36, 0x80, v36
v_cmp_gt_u32 vcc, 196, v36
s_and_saveexec_b64 s[38:39], vcc
s_cbranch_execz LMDONE
s_branch LNODE
LMDONE:
s_mov_b64 exec, -1
s_waitcnt lgkmcnt(0)
s_barrier
s_mov_b32 s45, s46
s_branch LROUND
LEPI:
s_cmp_ge_u32 s36, 13
s_cbranch_scc1 L2end
buffer_load_ushort v80, v15, s[24:27], 0 offen offset:0
buffer_load_ushort v81, v15, s[24:27], 0 offen offset:128
buffer_load_ushort v82, v15, s[24:27], 0 offen offset:256
buffer_load_ushort v83, v15, s[24:27], 0 offen offset:384
buffer_load_ushort v84, v15, s[24:27], 0 offen offset:512
buffer_load_ushort v85, v15, s[24:27], 0 offen offset:640
buffer_load_ushort v86, v15, s[24:27], 0 offen offset:768
buffer_load_ushort v87, v15, s[24:27], 0 offen offset:896
s_waitcnt vmcnt(0)
v_lshl_or_b32 v40, v81, 16, v80
v_lshl_or_b32 v41, v83, 16, v82
v_lshl_or_b32 v42, v85, 16, v84
v_lshl_or_b32 v43, v87, 16, v86
buffer_load_ushort v80, v19, s[24:27], 0 offen offset:0
buffer_load_ushort v81, v19, s[24:27], 0 offen offset:128
buffer_load_ushort v82, v19, s[24:27], 0 offen offset:256
buffer_load_ushort v83, v19, s[24:27], 0 offen offset:384
buffer_load_ushort v84, v19, s[24:27], 0 offen offset:512
buffer_load_ushort v85, v19, s[24:27], 0 offen offset:640
buffer_load_ushort v86, v19, s[24:27], 0 offen offset:768
buffer_load_ushort v87, v19, s[24:27], 0 offen offset:896
s_waitcnt vmcnt(0)
v_lshl_or_b32 v44, v81, 16, v80
v_lshl_or_b32 v45, v83, 16, v82
v_lshl_or_b32 v46, v85, 16, v84
v_lshl_or_b32 v47, v87, 16, v86
buffer_load_ushort v80, v15, s[24:27], 0 offen offset:32
buffer_load_ushort v81, v15, s[24:27], 0 offen offset:160
buffer_load_ushort v82, v15, s[24:27], 0 offen offset:288
buffer_load_ushort v83, v15, s[24:27], 0 offen offset:416
buffer_load_ushort v84, v15, s[24:27], 0 offen offset:544
buffer_load_ushort v85, v15, s[24:27], 0 offen offset:672
buffer_load_ushort v86, v15, s[24:27], 0 offen offset:800
buffer_load_ushort v87, v15, s[24:27], 0 offen offset:928
s_waitcnt vmcnt(0)
v_lshl_or_b32 v48, v81, 16, v80
v_lshl_or_b32 v49, v83, 16, v82
v_lshl_or_b32 v50, v85, 16, v84
v_lshl_or_b32 v51, v87, 16, v86
buffer_load_ushort v80, v19, s[24:27], 0 offen offset:32
buffer_load_ushort v81, v19, s[24:27], 0 offen offset:160
buffer_load_ushort v82, v19, s[24:27], 0 offen offset:288
buffer_load_ushort v83, v19, s[24:27], 0 offen offset:416
buffer_load_ushort v84, v19, s[24:27], 0 offen offset:544
buffer_load_ushort v85, v19, s[24:27], 0 offen offset:672
buffer_load_ushort v86, v19, s[24:27], 0 offen offset:800
buffer_load_ushort v87, v19, s[24:27], 0 offen offset:928
s_waitcnt vmcnt(0)
v_lshl_or_b32 v52, v81, 16, v80
v_lshl_or_b32 v53, v83, 16, v82
v_lshl_or_b32 v54, v85, 16, v84
v_lshl_or_b32 v55, v87, 16, v86
buffer_load_ushort v80, v15, s[24:27], 0 offen offset:64
buffer_load_ushort v81, v15, s[24:27], 0 offen offset:192
buffer_load_ushort v82, v15, s[24:27], 0 offen offset:320
buffer_load_ushort v83, v15, s[24:27], 0 offen offset:448
buffer_load_ushort v84, v15, s[24:27], 0 offen offset:576
buffer_load_ushort v85, v15, s[24:27], 0 offen offset:704
buffer_load_ushort v86, v15, s[24:27], 0 offen offset:832
buffer_load_ushort v87, v15, s[24:27], 0 offen offset:960
s_waitcnt vmcnt(0)
v_lshl_or_b32 v56, v81, 16, v80
v_lshl_or_b32 v57, v83, 16, v82
v_lshl_or_b32 v58, v85, 16, v84
v_lshl_or_b32 v59, v87, 16, v86
buffer_load_ushort v80, v19, s[24:27], 0 offen offset:64
buffer_load_ushort v81, v19, s[24:27], 0 offen offset:192
buffer_load_ushort v82, v19, s[24:27], 0 offen offset:320
buffer_load_ushort v83, v19, s[24:27], 0 offen offset:448
buffer_load_ushort v84, v19, s[24:27], 0 offen offset:576
buffer_load_ushort v85, v19, s[24:27], 0 offen offset:704
buffer_load_ushort v86, v19, s[24:27], 0 offen offset:832
buffer_load_ushort v87, v19, s[24:27], 0 offen offset:960
s_waitcnt vmcnt(0)
v_lshl_or_b32 v60, v81, 16, v80
v_lshl_or_b32 v61, v83, 16, v82
v_lshl_or_b32 v62, v85, 16, v84
v_lshl_or_b32 v63, v87, 16, v86
buffer_load_ushort v80, v15, s[24:27], 0 offen offset:96
buffer_load_ushort v81, v15, s[24:27], 0 offen offset:224
buffer_load_ushort v82, v15, s[24:27], 0 offen offset:352
buffer_load_ushort v83, v15, s[24:27], 0 offen offset:480
buffer_load_ushort v84, v15, s[24:27], 0 offen offset:608
buffer_load_ushort v85, v15, s[24:27], 0 offen offset:736
buffer_load_ushort v86, v15, s[24:27], 0 offen offset:864
buffer_load_ushort v87, v15, s[24:27], 0 offen offset:992
s_waitcnt vmcnt(0)
v_lshl_or_b32 v64, v81, 16, v80
v_lshl_or_b32 v65, v83, 16, v82
v_lshl_or_b32 v66, v85, 16, v84
v_lshl_or_b32 v67, v87, 16, v86
buffer_load_ushort v80, v19, s[24:27], 0 offen offset:96
buffer_load_ushort v81, v19, s[24:27], 0 offen offset:224
buffer_load_ushort v82, v19, s[24:27], 0 offen offset:352
buffer_load_ushort v83, v19, s[24:27], 0 offen offset:480
buffer_load_ushort v84, v19, s[24:27], 0 offen offset:608
buffer_load_ushort v85, v19, s[24:27], 0 offen offset:736
buffer_load_ushort v86, v19, s[24:27], 0 offen offset:864
buffer_load_ushort v87, v19, s[24:27], 0 offen offset:992
s_waitcnt vmcnt(0)
v_lshl_or_b32 v68, v81, 16, v80
v_lshl_or_b32 v69, v83, 16, v82
v_lshl_or_b32 v70, v85, 16, v84
v_lshl_or_b32 v71, v87, 16, v86
s_lshl_b32 s40, s36, 12
s_add_u32 s40, s40, 75776
v_lshlrev_b32 v16, 8, v13
v_lshl_add_u32 v16, v14, 5, v16
v_add_u32 v16, s40, v16
ds_read_b128 v[84:87], v16 offset:0
ds_read_b128 v[88:91], v16 offset:16
s_waitcnt lgkmcnt(0)
v_cvt_pk_bf16_f32 v72, v84, v85
v_lshlrev_b32 v100, 16, v72
v_and_b32 v101, 0xffff0000, v72
v_sub_f32 v100, v84, v100
v_sub_f32 v101, v85, v101
v_cvt_pk_bf16_f32 v92, v100, v101
v_cvt_pk_bf16_f32 v73, v86, v87
v_lshlrev_b32 v100, 16, v73
v_and_b32 v101, 0xffff0000, v73
v_sub_f32 v100, v86, v100
v_sub_f32 v101, v87, v101
v_cvt_pk_bf16_f32 v93, v100, v101
v_cvt_pk_bf16_f32 v74, v88, v89
v_lshlrev_b32 v100, 16, v74
v_and_b32 v101, 0xffff0000, v74
v_sub_f32 v100, v88, v100
v_sub_f32 v101, v89, v101
v_cvt_pk_bf16_f32 v94, v100, v101
v_cvt_pk_bf16_f32 v75, v90, v91
v_lshlrev_b32 v100, 16, v75
v_and_b32 v101, 0xffff0000, v75
v_sub_f32 v100, v90, v100
v_sub_f32 v101, v91, v101
v_cvt_pk_bf16_f32 v95, v100, v101
ds_read_b128 v[84:87], v16 offset:128
ds_read_b128 v[88:91], v16 offset:144
s_waitcnt lgkmcnt(0)
v_cvt_pk_bf16_f32 v76, v84, v85
v_lshlrev_b32 v100, 16, v76
v_and_b32 v101, 0xffff0000, v76
v_sub_f32 v100, v84, v100
v_sub_f32 v101, v85, v101
v_cvt_pk_bf16_f32 v96, v100, v101
v_cvt_pk_bf16_f32 v77, v86, v87
v_lshlrev_b32 v100, 16, v77
v_and_b32 v101, 0xffff0000, v77
v_sub_f32 v100, v86, v100
v_sub_f32 v101, v87, v101
v_cvt_pk_bf16_f32 v97, v100, v101
v_cvt_pk_bf16_f32 v78, v88, v89
v_lshlrev_b32 v100, 16, v78
v_and_b32 v101, 0xffff0000, v78
v_sub_f32 v100, v88, v100
v_sub_f32 v101, v89, v101
v_cvt_pk_bf16_f32 v98, v100, v101
v_cvt_pk_bf16_f32 v79, v90, v91
v_lshlrev_b32 v100, 16, v79
v_and_b32 v101, 0xffff0000, v79
v_sub_f32 v100, v90, v100
v_sub_f32 v101, v91, v101
v_cvt_pk_bf16_f32 v99, v100, v101
s_lshl_b32 s40, s36, 11
s_add_u32 s40, s40, s37
v_lshlrev_b32 v17, 9, v14
v_lshl_add_u32 v17, v13, 1, v17
s_lshl_b32 s41, s36, 4
v_lshl_add_u32 v18, v14, 2, s41
v_cmp_gt_u32 vcc, 196, v18
s_and_saveexec_b64 s[38:39], vcc
s_cbranch_execz L2end
v_mfma_f32_16x16x32_bf16 v[104:107], v[72:75], v[40:43], 0
v_mfma_f32_16x16x32_bf16 v[104:107], v[76:79], v[44:47], v[104:107]
v_mfma_f32_16x16x32_bf16 v[104:107], v[92:95], v[40:43], v[104:107]
v_mfma_f32_16x16x32_bf16 v[104:107], v[96:99], v[44:47], v[104:107]
s_nop 7
v_cvt_pk_bf16_f32 v104, v104, v105
v_cvt_pk_bf16_f32 v106, v106, v107
buffer_store_short v104, v17, s[28:31], s40 offen offset:0
buffer_store_short_d16_hi v104, v17, s[28:31], s40 offen offset:128
buffer_store_short v106, v17, s[28:31], s40 offen offset:256
buffer_store_short_d16_hi v106, v17, s[28:31], s40 offen offset:384
v_mfma_f32_16x16x32_bf16 v[104:107], v[72:75], v[48:51], 0
v_mfma_f32_16x16x32_bf16 v[104:107], v[76:79], v[52:55], v[104:107]
v_mfma_f32_16x16x32_bf16 v[104:107], v[92:95], v[48:51], v[104:107]
v_mfma_f32_16x16x32_bf16 v[104:107], v[96:99], v[52:55], v[104:107]
s_nop 7
v_cvt_pk_bf16_f32 v104, v104, v105
v_cvt_pk_bf16_f32 v106, v106, v107
buffer_store_short v104, v17, s[28:31], s40 offen offset:32
buffer_store_short_d16_hi v104, v17, s[28:31], s40 offen offset:160
buffer_store_short v106, v17, s[28:31], s40 offen offset:288
buffer_store_short_d16_hi v106, v17, s[28:31], s40 offen offset:416
v_mfma_f32_16x16x32_bf16 v[104:107], v[72:75], v[56:59], 0
v_mfma_f32_16x16x32_bf16 v[104:107], v[76:79], v[60:63], v[104:107]
v_mfma_f32_16x16x32_bf16 v[104:107], v[92:95], v[56:59], v[104:107]
v_mfma_f32_16x16x32_bf16 v[104:107], v[96:99], v[60:63], v[104:107]
s_nop 7
v_cvt_pk_bf16_f32 v104, v104, v105
v_cvt_pk_bf16_f32 v106, v106, v107
buffer_store_short v104, v17, s[28:31], s40 offen offset:64
buffer_store_short_d16_hi v104, v17, s[28:31], s40 offen offset:192
buffer_store_short v106, v17, s[28:31], s40 offen offset:320
buffer_store_short_d16_hi v106, v17, s[28:31], s40 offen offset:448
v_mfma_f32_16x16x32_bf16 v[104:107], v[72:75], v[64:67], 0
v_mfma_f32_16x16x32_bf16 v[104:107], v[76:79], v[68:71], v[104:107]
v_mfma_f32_16x16x32_bf16 v[104:107], v[92:95], v[64:67], v[104:107]
v_mfma_f32_16x16x32_bf16 v[104:107], v[96:99], v[68:71], v[104:107]
s_nop 7
v_cvt_pk_bf16_f32 v104, v104, v105
v_cvt_pk_bf16_f32 v106, v106, v107
buffer_store_short v104, v17, s[28:31], s40 offen offset:96
buffer_store_short_d16_hi v104, v17, s[28:31], s40 offen offset:224
buffer_store_short v106, v17, s[28:31], s40 offen offset:352
buffer_store_short_d16_hi v106, v17, s[28:31], s40 offen offset:480
L2end:
s_endpgm
.section .rodata,"a"
.p2align 6
.amdhsa_kernel sort_kernel
  .amdhsa_next_free_vgpr 64
  .amdhsa_next_free_sgpr 102
  .amdhsa_accum_offset 64
  .amdhsa_group_segment_fixed_size 0
  .amdhsa_kernarg_size 64
  .amdhsa_user_sgpr_count 2
  .amdhsa_user_sgpr_kernarg_segment_ptr 1
  .amdhsa_system_sgpr_workgroup_id_x 1
.end_amdhsa_kernel
.p2align 6
.amdhsa_kernel standalone__kernel_systems_refs_featgraph__graph_kernel
  .amdhsa_next_free_vgpr 128
  .amdhsa_next_free_sgpr 102
  .amdhsa_accum_offset 128
  .amdhsa_group_segment_fixed_size 0
  .amdhsa_kernarg_size 64
  .amdhsa_user_sgpr_count 2
  .amdhsa_user_sgpr_kernarg_segment_ptr 1
  .amdhsa_system_sgpr_workgroup_id_x 1
.end_amdhsa_kernel
```
